```python
import torch

def _softmax(x, axis=-1):
    return torch.softmax(x, dim=axis)
def _gelu(x):
    return torch.nn.functional.gelu(x, approximate="tanh")
def _silu(x):
    return torch.nn.functional.silu(x)
def _sigmoid(x):
    return torch.sigmoid(x)
def _layernorm(x, axis=-1, eps=1e-5):
    m = x.mean(dim=axis, keepdim=True)
    v = x.var(dim=axis, keepdim=True, unbiased=False)
    return (x - m) / torch.sqrt(v + eps)
def _scatter_add(tgt, idx, src, axis=0):
    return tgt.clone().index_add_(axis, idx, src)
def _segment_sum(src, seg, n):
    out = torch.zeros((n,) + src.shape[1:], dtype=src.dtype)
    return out.index_add_(0, seg, src)
def _pad(x, pw):
    flat = tuple(v for pair in reversed(pw) for v in pair)
    return torch.nn.functional.pad(x, flat)

kernel_name = 'concat_heads__gqa_block_cached__gqa_block_cached__decode'

def setup_inputs():

    _w = (lambda a: (lambda t: t.to(torch.bfloat16) if t.is_floating_point() else t)(torch.as_tensor(a)))
    def _A_setup():
        B, Sq, D = 4, 1, 448
        Hq, Hkv, Sk, Dh = 16, 8, 8192, 256
        assert Hq % Hkv == 0, (Hq, Hkv)
        return {
            "x": _w((lambda *s: torch.randn(*s, dtype=torch.bfloat16) * 0.8)(B, Sq, D)),
            "k_cache": _w((lambda *s: torch.randn(*s, dtype=torch.bfloat16) * 0.8)(B, Hkv, Sk, Dh)),
            "v_cache": _w((lambda *s: torch.randn(*s, dtype=torch.bfloat16) * 0.05)(B, Hkv, Sk, Dh)),
            "wq": _w((lambda *s: torch.randn(*s, dtype=torch.bfloat16) * 0.8)(D, Hq * Dh) * (D ** -0.5)),
            "wo": _w((lambda *s: torch.randn(*s, dtype=torch.bfloat16) * 0.05)(Hq * Dh, D) * ((Hq * Dh) ** -0.5)),
        }
    _A_in = _A_setup()

    def _B_setup():
        B, Sq, D = 4, 1, 448
        Hq, Hkv, Sk, Dh = 16, 8, 8192, 256
        assert Hq % Hkv == 0, (Hq, Hkv)
        return {
            "x": _w((lambda *s: torch.randn(*s, dtype=torch.bfloat16) * 0.8)(B, Sq, D)),
            "k_cache": _w((lambda *s: torch.randn(*s, dtype=torch.bfloat16) * 0.8)(B, Hkv, Sk, Dh)),
            "v_cache": _w((lambda *s: torch.randn(*s, dtype=torch.bfloat16) * 0.05)(B, Hkv, Sk, Dh)),
            "wq": _w((lambda *s: torch.randn(*s, dtype=torch.bfloat16) * 0.8)(D, Hq * Dh) * (D ** -0.5)),
            "wo": _w((lambda *s: torch.randn(*s, dtype=torch.bfloat16) * 0.05)(Hq * Dh, D) * ((Hq * Dh) ** -0.5)),
        }
    _B_in = _B_setup()

    return {
        "A_x": _A_in["x"],
        "A_k_cache": _A_in["k_cache"],
        "A_v_cache": _A_in["v_cache"],
        "A_wq": _A_in["wq"],
        "A_wo": _A_in["wo"],
        "B_x": _B_in["x"],
        "B_k_cache": _B_in["k_cache"],
        "B_v_cache": _B_in["v_cache"],
        "B_wq": _B_in["wq"],
        "B_wo": _B_in["wo"],
    }

def reference(A_x, A_k_cache, A_v_cache, A_wq, A_wo, B_x, B_k_cache, B_v_cache, B_wq, B_wo):
    def _A_ref(x, k_cache, v_cache, wq, wo):
        B, Sq, D = x.shape
        Hq, Dh = 16, 256
        Hkv = k_cache.shape[1]
        rep = Hq // Hkv
        q = (lambda x, *d: x.permute(*d))((x @ wq).reshape(B, Sq, Hq, Dh), 0, 2, 1, 3)
        k = (lambda x, n, axis: torch.repeat_interleave(x, n, dim=axis))(k_cache, rep, axis=1)
        v = (lambda x, n, axis: torch.repeat_interleave(x, n, dim=axis))(v_cache, rep, axis=1)
        scores = torch.einsum("bhqd,bhkd->bhqk", q, k) * (Dh ** -0.5)
        p = _softmax(scores, axis=-1)
        o = torch.einsum("bhqk,bhkd->bhqd", p, v)
        return (lambda x, *d: x.permute(*d))(o, 0, 2, 1, 3).reshape(B, Sq, Hq * Dh) @ wo

    def _B_ref(x, k_cache, v_cache, wq, wo):
        B, Sq, D = x.shape
        Hq, Dh = 16, 256
        Hkv = k_cache.shape[1]
        rep = Hq // Hkv
        q = (lambda x, *d: x.permute(*d))((x @ wq).reshape(B, Sq, Hq, Dh), 0, 2, 1, 3)
        k = (lambda x, n, axis: torch.repeat_interleave(x, n, dim=axis))(k_cache, rep, axis=1)
        v = (lambda x, n, axis: torch.repeat_interleave(x, n, dim=axis))(v_cache, rep, axis=1)
        scores = torch.einsum("bhqd,bhkd->bhqk", q, k) * (Dh ** -0.5)
        p = _softmax(scores, axis=-1)
        o = torch.einsum("bhqk,bhkd->bhqd", p, v)
        return (lambda x, *d: x.permute(*d))(o, 0, 2, 1, 3).reshape(B, Sq, Hq * Dh) @ wo

    a = _A_ref(A_x, A_k_cache, A_v_cache, A_wq, A_wo)
    b = _B_ref(B_x, B_k_cache, B_v_cache, B_wq, B_wo)
    return torch.concatenate([a, b], axis=-1)
```

```asm
; @launch grid=(256,1,1) block=(512,1,1) lds=24576
.amdgcn_target "amdgcn-amd-amdhsa--gfx950"
.text
.globl concat_heads__gqa_block_cached__gqa_block_cached__decode_kernel
.p2align 8
.type concat_heads__gqa_block_cached__gqa_block_cached__decode_kernel,@function
concat_heads__gqa_block_cached__gqa_block_cached__decode_kernel:
    s_cmp_ge_u32 s2, 256
    s_cbranch_scc1 L_end
    s_load_dwordx8 s[20:27], s[0:1], 0
    s_load_dwordx2 s[28:29], s[0:1], 32
    s_load_dwordx8 s[32:39], s[0:1], 40
    s_load_dwordx2 s[40:41], s[0:1], 72
    s_load_dwordx4 s[44:47], s[0:1], 80
    s_load_dwordx2 s[48:49], s[0:1], 96
    v_lshrrev_b32 v10, 6, v0
    v_and_b32 v1, 63, v0
    v_readfirstlane_b32 s18, v10
    s_lshr_b32 s15, s2, 3
    s_and_b32 s15, s15, 3
    s_and_b32 s14, s2, 7
    s_and_b32 s89, s15, 1
    s_lshr_b32 s90, s15, 1
    s_lshl_b32 s90, s90, 2
    s_add_u32 s89, s89, s90
    s_sub_u32 s14, s14, s89
    s_and_b32 s14, s14, 7
    s_lshr_b32 s16, s2, 5
    s_and_b32 s16, s16, 3
    s_lshr_b32 s17, s2, 7
    s_lshr_b32 s89, s2, 5
    s_lshl_b32 s19, s89, 3
    s_or_b32 s19, s19, s14
    s_lshl_b32 s50, s89, 2
    s_or_b32 s50, s50, s15
    s_and_b32 s3, s50, 7
    s_lshl_b32 s91, s89, 7
    s_mov_b32 s92, 0x3db8aa3b
    s_mov_b32 s93, 0x01000100
    s_mov_b32 s94, 0x03020302
    v_lshrrev_b32 v10, 4, v1
    v_and_b32 v11, 15, v1
    v_bfe_u32 v12, v1, 2, 2
    v_lshlrev_b32 v12, 9, v12
    v_lshl_add_u32 v12, v10, 6, v12
    v_and_b32 v13, 3, v1
    v_lshl_add_u32 v2, v13, 4, v12
    v_lshlrev_b32 v12, 9, v10
    v_lshl_add_u32 v3, v11, 4, v12
    v_and_b32 v12, 1, v1
    v_lshlrev_b32 v12, 4, v12
    v_mov_b32 v13, 0xffff
    v_lshlrev_b32 v13, v12, v13
    v_bfe_u32 v12, v1, 1, 2
    v_cmp_eq_u32 vcc, 0, v12
    s_nop 1
    v_cndmask_b32 v4, 0, v13, vcc
    v_cmp_eq_u32 vcc, 1, v12
    s_nop 1
    v_cndmask_b32 v5, 0, v13, vcc
    v_cmp_eq_u32 vcc, 2, v12
    s_nop 1
    v_cndmask_b32 v6, 0, v13, vcc
    v_cmp_eq_u32 vcc, 3, v12
    s_nop 1
    v_cndmask_b32 v7, 0, v13, vcc
    s_waitcnt lgkmcnt(0)
    s_mov_b32 s72, s48
    s_mov_b32 s73, s49
    s_mov_b32 s74, 0x1000000
    s_mov_b32 s75, 0x00020000
    v_mov_b32 v62, s91
    buffer_load_dwordx2 v[62:63], v62, s[72:75], 0 offen offset:0 sc1
    s_cmp_eq_u32 s17, 0
    s_cselect_b64 s[4:5], s[20:21], s[32:33]
    s_cselect_b64 s[6:7], s[22:23], s[34:35]
    s_cselect_b64 s[8:9], s[24:25], s[36:37]
    s_cselect_b64 s[10:11], s[26:27], s[38:39]
    s_cselect_b64 s[12:13], s[28:29], s[40:41]
    s_mov_b32 s68, s4
    s_mov_b32 s69, s5
    s_mov_b32 s70, 3584
    s_mov_b32 s71, 0x00020000
    s_mul_i32 s89, s18, 458752
    s_lshl_b32 s90, s14, 10
    s_add_u32 s89, s89, s90
    s_lshl_b32 s90, s15, 8
    s_add_u32 s89, s89, s90
    s_sub_u32 s90, 3670016, s89
    s_add_u32 s60, s10, s89
    s_addc_u32 s61, s11, 0
    s_mov_b32 s62, s90
    s_mov_b32 s63, 0x00020000
    s_mul_i32 s89, s16, 896
    s_mul_i32 s90, s18, 112
    s_add_u32 s89, s89, s90
    v_mul_u32_u24 v12, 28, v10
    buffer_load_dwordx4 v[40:43], v12, s[68:71], s89 offen
    buffer_load_dwordx4 v[44:47], v12, s[68:71], s89 offen offset:16
    v_mul_u32_u24 v12, 7168, v10
    v_add_lshl_u32 v12, v12, v11, 4
    s_mov_b32 s89, 0
    buffer_load_dwordx4 v[200:203], v12, s[60:63], s89 offen
    s_add_u32 s89, s89, 8192
    buffer_load_dwordx4 v[204:207], v12, s[60:63], s89 offen
    s_add_u32 s89, s89, 8192
    buffer_load_dwordx4 v[208:211], v12, s[60:63], s89 offen
    s_add_u32 s89, s89, 8192
    buffer_load_dwordx4 v[212:215], v12, s[60:63], s89 offen
    s_add_u32 s89, s89, 8192
    buffer_load_dwordx4 v[216:219], v12, s[60:63], s89 offen
    s_add_u32 s89, s89, 8192
    buffer_load_dwordx4 v[220:223], v12, s[60:63], s89 offen
    s_add_u32 s89, s89, 8192
    buffer_load_dwordx4 v[224:227], v12, s[60:63], s89 offen
    s_add_u32 s89, s89, 8192
    buffer_load_dwordx4 v[228:231], v12, s[60:63], s89 offen
    s_add_u32 s89, s89, 8192
    buffer_load_dwordx4 v[232:235], v12, s[60:63], s89 offen
    s_add_u32 s89, s89, 8192
    buffer_load_dwordx4 v[236:239], v12, s[60:63], s89 offen
    s_add_u32 s89, s89, 8192
    buffer_load_dwordx4 v[240:243], v12, s[60:63], s89 offen
    s_add_u32 s89, s89, 8192
    buffer_load_dwordx4 v[244:247], v12, s[60:63], s89 offen
    s_add_u32 s89, s89, 8192
    buffer_load_dwordx4 v[248:251], v12, s[60:63], s89 offen
    s_add_u32 s89, s89, 8192
    buffer_load_dwordx4 v[252:255], v12, s[60:63], s89 offen
    s_lshl_b32 s89, s16, 3
    s_or_b32 s89, s89, s14
    s_lshl_b32 s89, s89, 22
    s_add_u32 s52, s6, s89
    s_addc_u32 s53, s7, 0
    s_mov_b32 s54, 0x400000
    s_mov_b32 s55, 0x00020000
    s_add_u32 s56, s8, s89
    s_addc_u32 s57, s9, 0
    s_mov_b32 s58, 0x400000
    s_mov_b32 s59, 0x00020000
    s_mov_b32 s80, s44
    s_mov_b32 s81, s45
    s_mov_b32 s82, 7168
    s_mov_b32 s83, 0x00020000
    s_mul_i32 s91, s19, 2048
    s_add_u32 s91, s91, 8388608
    s_add_u32 s66, s48, s91
    s_addc_u32 s67, s49, 0
    v_mov_b32 v37, 5248
    v_mov_b32 v38, 1
    s_or_b32 s89, s15, s18
    s_cmp_lg_u32 s89, 0
    s_cbranch_scc1 L_noinit
    v_mov_b32 v12, s91
    v_mov_b32 v13, 448
    s_mov_b64 exec, 1
    buffer_store_dword v13, v12, s[72:75], 0 offen sc1
    s_mov_b64 exec, -1
L_noinit:
    s_mul_i32 s43, s15, 112
    s_add_u32 s98, s43, s18
    s_add_u32 s99, s98, 8
    s_cmp_ge_u32 s18, 3
    s_cselect_b32 s99, 512, s99
    s_mov_b32 s101, 0
    s_lshl_b32 s84, s98, 13
    s_add_u32 s85, s84, 4096
    s_lshl_b32 s89, s14, 9
    s_lshl_b32 s90, s18, 6
    s_add_u32 s89, s89, s90
    s_mul_i32 s89, s89, 896
    s_lshl_b32 s90, s15, 8
    s_add_u32 s89, s89, s90
    s_sub_u32 s90, 3670016, s89
    s_add_u32 s36, s12, s89
    s_addc_u32 s37, s13, 0
    s_mov_b32 s38, s90
    s_mov_b32 s39, 0x00020000
    v_mul_u32_u24 v12, 896, v10
    v_add_lshl_u32 v12, v12, v11, 4
    s_cmp_eq_u32 s15, 3
    s_cselect_b32 s20, 64, 128
    v_lshlrev_b32 v13, 3, v11
    v_cmp_le_u32 vcc, s20, v13
    v_mov_b32 v13, 0x40000000
    s_nop 0
    v_cndmask_b32 v39, v12, v13, vcc
    s_cmp_eq_u32 s18, 0
    s_cbranch_scc1 L_nopre
    buffer_load_dwordx4 v[72:75], v2, s[52:55], s84 offen offset:0 nt
    buffer_load_dwordx4 v[76:79], v2, s[52:55], s84 offen offset:256 nt
    buffer_load_dwordx4 v[80:83], v2, s[52:55], s84 offen offset:2048 nt
    buffer_load_dwordx4 v[84:87], v2, s[52:55], s84 offen offset:2304 nt
    buffer_load_dwordx4 v[88:91], v2, s[52:55], s85 offen offset:0 nt
    buffer_load_dwordx4 v[92:95], v2, s[52:55], s85 offen offset:256 nt
    buffer_load_dwordx4 v[96:99], v2, s[52:55], s85 offen offset:2048 nt
    buffer_load_dwordx4 v[100:103], v2, s[52:55], s85 offen offset:2304 nt
L_nopre:
    s_cmp_eq_u32 s18, 0
    s_cbranch_scc1 L_w0w
    s_waitcnt vmcnt(8)
    s_branch L_qc
L_w0w:
    s_waitcnt vmcnt(0)
L_qc:
    v_readfirstlane_b32 s78, v62
    v_readfirstlane_b32 s79, v63
    s_nop 3
    s_add_u32 s78, s78, 1
    s_addc_u32 s79, s79, 0
    s_mov_b32 s76, s78
    s_brev_b32 s77, s78
    s_xor_b32 s77, s77, s79
    v_perm_b32 v60, v40, v40, s93
    v_and_b32 v48, v60, v4
    v_and_b32 v49, v60, v5
    v_and_b32 v50, v60, v6
    v_and_b32 v51, v60, v7
    s_nop 1
    v_mfma_f32_16x16x32_bf16 v[56:59], v[200:203], v[48:51], 0
    v_perm_b32 v60, v40, v40, s94
    v_and_b32 v52, v60, v4
    v_and_b32 v53, v60, v5
    v_and_b32 v54, v60, v6
    v_and_b32 v55, v60, v7
    s_nop 1
    v_mfma_f32_16x16x32_bf16 v[56:59], v[204:207], v[52:55], v[56:59]
    v_perm_b32 v60, v41, v41, s93
    v_and_b32 v48, v60, v4
    v_and_b32 v49, v60, v5
    v_and_b32 v50, v60, v6
    v_and_b32 v51, v60, v7
    s_nop 1
    v_mfma_f32_16x16x32_bf16 v[56:59], v[208:211], v[48:51], v[56:59]
    v_perm_b32 v60, v41, v41, s94
    v_and_b32 v52, v60, v4
    v_and_b32 v53, v60, v5
    v_and_b32 v54, v60, v6
    v_and_b32 v55, v60, v7
    s_nop 1
    v_mfma_f32_16x16x32_bf16 v[56:59], v[212:215], v[52:55], v[56:59]
    v_perm_b32 v60, v42, v42, s93
    v_and_b32 v48, v60, v4
    v_and_b32 v49, v60, v5
    v_and_b32 v50, v60, v6
    v_and_b32 v51, v60, v7
    s_nop 1
    v_mfma_f32_16x16x32_bf16 v[56:59], v[216:219], v[48:51], v[56:59]
    v_perm_b32 v60, v42, v42, s94
    v_and_b32 v52, v60, v4
    v_and_b32 v53, v60, v5
    v_and_b32 v54, v60, v6
    v_and_b32 v55, v60, v7
    s_nop 1
    v_mfma_f32_16x16x32_bf16 v[56:59], v[220:223], v[52:55], v[56:59]
    v_perm_b32 v60, v43, v43, s93
    v_and_b32 v48, v60, v4
    v_and_b32 v49, v60, v5
    v_and_b32 v50, v60, v6
    v_and_b32 v51, v60, v7
    s_nop 1
    v_mfma_f32_16x16x32_bf16 v[56:59], v[224:227], v[48:51], v[56:59]
    v_perm_b32 v60, v43, v43, s94
    v_and_b32 v52, v60, v4
    v_and_b32 v53, v60, v5
    v_and_b32 v54, v60, v6
    v_and_b32 v55, v60, v7
    s_nop 1
    v_mfma_f32_16x16x32_bf16 v[56:59], v[228:231], v[52:55], v[56:59]
    v_perm_b32 v60, v44, v44, s93
    v_and_b32 v48, v60, v4
    v_and_b32 v49, v60, v5
    v_and_b32 v50, v60, v6
    v_and_b32 v51, v60, v7
    s_nop 1
    v_mfma_f32_16x16x32_bf16 v[56:59], v[232:235], v[48:51], v[56:59]
    v_perm_b32 v60, v44, v44, s94
    v_and_b32 v52, v60, v4
    v_and_b32 v53, v60, v5
    v_and_b32 v54, v60, v6
    v_and_b32 v55, v60, v7
    s_nop 1
    v_mfma_f32_16x16x32_bf16 v[56:59], v[236:239], v[52:55], v[56:59]
    v_perm_b32 v60, v45, v45, s93
    v_and_b32 v48, v60, v4
    v_and_b32 v49, v60, v5
    v_and_b32 v50, v60, v6
    v_and_b32 v51, v60, v7
    s_nop 1
    v_mfma_f32_16x16x32_bf16 v[56:59], v[240:243], v[48:51], v[56:59]
    v_perm_b32 v60, v45, v45, s94
    v_and_b32 v52, v60, v4
    v_and_b32 v53, v60, v5
    v_and_b32 v54, v60, v6
    v_and_b32 v55, v60, v7
    s_nop 1
    v_mfma_f32_16x16x32_bf16 v[56:59], v[244:247], v[52:55], v[56:59]
    v_perm_b32 v60, v46, v46, s93
    v_and_b32 v48, v60, v4
    v_and_b32 v49, v60, v5
    v_and_b32 v50, v60, v6
    v_and_b32 v51, v60, v7
    s_nop 1
    v_mfma_f32_16x16x32_bf16 v[56:59], v[248:251], v[48:51], v[56:59]
    v_perm_b32 v60, v46, v46, s94
    v_and_b32 v52, v60, v4
    v_and_b32 v53, v60, v5
    v_and_b32 v54, v60, v6
    v_and_b32 v55, v60, v7
    s_nop 1
    v_mfma_f32_16x16x32_bf16 v[56:59], v[252:255], v[52:55], v[56:59]
    v_and_b32 v12, 7, v1
    v_lshlrev_b32 v12, 2, v12
    v_lshl_add_u32 v12, v10, 7, v12
    s_lshl_b32 s89, s18, 9
    v_add_u32 v12, s89, v12
    v_mov_b32 v13, 11
    v_mov_b32 v14, 0
    s_nop 5
    ds_write_b32 v12, v56 offset:0
    ds_write_b32 v12, v57 offset:32
    ds_write_b32 v12, v58 offset:64
    ds_write_b32 v12, v59 offset:96
    ds_write_b32 v37, v13
    ds_write_b32 v37, v14 offset:4
    s_waitcnt lgkmcnt(0)
    s_barrier
    s_cmp_lg_u32 s18, 0
    s_cbranch_scc1 L_paced
    v_lshlrev_b32 v12, 4, v1
    v_and_b32 v12, 0x1ff, v12
    ds_read_b128 v[72:75], v12 offset:0
    ds_read_b128 v[76:79], v12 offset:512
    ds_read_b128 v[80:83], v12 offset:1024
    ds_read_b128 v[84:87], v12 offset:1536
    ds_read_b128 v[88:91], v12 offset:2048
    ds_read_b128 v[92:95], v12 offset:2560
    ds_read_b128 v[96:99], v12 offset:3072
    ds_read_b128 v[100:103], v12 offset:3584
    s_lshl_b32 s89, s19, 11
    s_add_u32 s89, s89, 16384
    s_lshl_b32 s90, s15, 9
    s_add_u32 s90, s90, s89
    s_waitcnt lgkmcnt(0)
    v_add_f32 v72, v72, v76
    v_add_f32 v73, v73, v77
    v_add_f32 v74, v74, v78
    v_add_f32 v75, v75, v79
    v_add_f32 v72, v72, v80
    v_add_f32 v73, v73, v81
    v_add_f32 v74, v74, v82
    v_add_f32 v75, v75, v83
    v_add_f32 v72, v72, v84
    v_add_f32 v73, v73, v85
    v_add_f32 v74, v74, v86
    v_add_f32 v75, v75, v87
    v_add_f32 v72, v72, v88
    v_add_f32 v73, v73, v89
    v_add_f32 v74, v74, v90
    v_add_f32 v75, v75, v91
    v_add_f32 v72, v72, v92
    v_add_f32 v73, v73, v93
    v_add_f32 v74, v74, v94
    v_add_f32 v75, v75, v95
    v_add_f32 v72, v72, v96
    v_add_f32 v73, v73, v97
    v_add_f32 v74, v74, v98
    v_add_f32 v75, v75, v99
    v_add_f32 v72, v72, v100
    v_add_f32 v73, v73, v101
    v_add_f32 v74, v74, v102
    v_add_f32 v75, v75, v103
    v_cvt_pk_bf16_f32 v40, v72, v73
    v_mov_b32 v41, s76
    v_cvt_pk_bf16_f32 v42, v74, v75
    v_mov_b32 v43, s77
    s_mov_b32 exec_hi, 0
    buffer_store_dwordx4 v[40:43], v12, s[72:75], s90 offen sc1
    s_mov_b64 exec, -1
    v_lshlrev_b32 v12, 4, v1
    s_mov_b32 s88, 131072
L_poll1:
    buffer_load_dwordx4 v[40:43], v12, s[72:75], s89 offen sc1
    buffer_load_dwordx4 v[44:47], v12, s[72:75], s89 offen offset:1024 sc1
    s_waitcnt vmcnt(0)
    v_cmp_ne_u32 vcc, s76, v41
    v_cmp_ne_u32 s[96:97], s77, v43
    s_or_b64 vcc, vcc, s[96:97]
    v_cmp_ne_u32 s[96:97], s76, v45
    s_or_b64 vcc, vcc, s[96:97]
    v_cmp_ne_u32 s[96:97], s77, v47
    s_or_b64 vcc, vcc, s[96:97]
    s_sub_u32 s88, s88, 1
    s_cbranch_scc1 L_poll1_done
    s_cmp_lg_u64 vcc, 0
    s_cbranch_scc1 L_poll1
L_poll1_done:
    v_mov_b32 v41, v42
    v_mov_b32 v45, v46
    v_lshlrev_b32 v12, 3, v1
    ds_write_b64 v12, v[40:41] offset:4096
    ds_write_b64 v12, v[44:45] offset:4608
    s_waitcnt lgkmcnt(0)
    ds_write_b32 v37, v38 offset:4
    buffer_load_dwordx4 v[72:75], v2, s[52:55], s84 offen offset:0 nt
    buffer_load_dwordx4 v[76:79], v2, s[52:55], s84 offen offset:256 nt
    buffer_load_dwordx4 v[80:83], v2, s[52:55], s84 offen offset:2048 nt
    buffer_load_dwordx4 v[84:87], v2, s[52:55], s84 offen offset:2304 nt
    buffer_load_dwordx4 v[88:91], v2, s[52:55], s85 offen offset:0 nt
    buffer_load_dwordx4 v[92:95], v2, s[52:55], s85 offen offset:256 nt
    buffer_load_dwordx4 v[96:99], v2, s[52:55], s85 offen offset:2048 nt
    buffer_load_dwordx4 v[100:103], v2, s[52:55], s85 offen offset:2304 nt
    buffer_load_dwordx4 v[104:107], v3, s[56:59], s84 offen offset:0 nt
    buffer_load_dwordx4 v[108:111], v3, s[56:59], s84 offen offset:256 nt
    buffer_load_dwordx4 v[112:115], v3, s[56:59], s84 offen offset:2048 nt
    buffer_load_dwordx4 v[116:119], v3, s[56:59], s84 offen offset:2304 nt
    buffer_load_dwordx4 v[120:123], v3, s[56:59], s85 offen offset:0 nt
    buffer_load_dwordx4 v[124:127], v3, s[56:59], s85 offen offset:256 nt
    buffer_load_dwordx4 v[128:131], v3, s[56:59], s85 offen offset:2048 nt
    buffer_load_dwordx4 v[132:135], v3, s[56:59], s85 offen offset:2304 nt
    s_mov_b32 s90, 0
    buffer_load_dwordx4 v[136:139], v39, s[36:39], s90 offen
    s_mov_b32 s90, 896
    buffer_load_dwordx4 v[140:143], v39, s[36:39], s90 offen
    s_mov_b32 s90, 1792
    buffer_load_dwordx4 v[144:147], v39, s[36:39], s90 offen
    s_mov_b32 s90, 2688
    buffer_load_dwordx4 v[148:151], v39, s[36:39], s90 offen
    s_mov_b32 s90, 3584
    buffer_load_dwordx4 v[152:155], v39, s[36:39], s90 offen
    s_mov_b32 s90, 4480
    buffer_load_dwordx4 v[156:159], v39, s[36:39], s90 offen
    s_mov_b32 s90, 5376
    buffer_load_dwordx4 v[160:163], v39, s[36:39], s90 offen
    s_mov_b32 s90, 6272
    buffer_load_dwordx4 v[164:167], v39, s[36:39], s90 offen
    s_mov_b32 s90, 7168
    buffer_load_dwordx4 v[168:171], v39, s[36:39], s90 offen
    s_mov_b32 s90, 8064
    buffer_load_dwordx4 v[172:175], v39, s[36:39], s90 offen
    s_mov_b32 s90, 8960
    buffer_load_dwordx4 v[176:179], v39, s[36:39], s90 offen
    s_mov_b32 s90, 9856
    buffer_load_dwordx4 v[180:183], v39, s[36:39], s90 offen
    s_mov_b32 s90, 10752
    buffer_load_dwordx4 v[184:187], v39, s[36:39], s90 offen
    s_mov_b32 s90, 11648
    buffer_load_dwordx4 v[188:191], v39, s[36:39], s90 offen
    s_mov_b32 s90, 12544
    buffer_load_dwordx4 v[192:195], v39, s[36:39], s90 offen
    s_mov_b32 s90, 13440
    buffer_load_dwordx4 v[196:199], v39, s[36:39], s90 offen
    s_branch L_go
L_paced:
    s_mov_b32 s21, 0
    s_cmp_lg_u32 s21, 0
    s_cbranch_scc1 L_pi8
    ds_read_b32 v13, v37 offset:4
    s_waitcnt lgkmcnt(0)
    v_readfirstlane_b32 s21, v13
    s_nop 3
    s_cmp_lg_u32 s21, 0
    s_cbranch_scc1 L_pi8
    s_waitcnt vmcnt(4)
L_pi8:
    buffer_load_dwordx4 v[104:107], v3, s[56:59], s84 offen offset:0 nt
    buffer_load_dwordx4 v[108:111], v3, s[56:59], s84 offen offset:256 nt
    buffer_load_dwordx4 v[112:115], v3, s[56:59], s84 offen offset:2048 nt
    buffer_load_dwordx4 v[116:119], v3, s[56:59], s84 offen offset:2304 nt
    s_cmp_lg_u32 s21, 0
    s_cbranch_scc1 L_pi12
    ds_read_b32 v13, v37 offset:4
    s_waitcnt lgkmcnt(0)
    v_readfirstlane_b32 s21, v13
    s_nop 3
    s_cmp_lg_u32 s21, 0
    s_cbranch_scc1 L_pi12
    s_waitcnt vmcnt(4)
L_pi12:
    buffer_load_dwordx4 v[120:123], v3, s[56:59], s85 offen offset:0 nt
    buffer_load_dwordx4 v[124:127], v3, s[56:59], s85 offen offset:256 nt
    buffer_load_dwordx4 v[128:131], v3, s[56:59], s85 offen offset:2048 nt
    buffer_load_dwordx4 v[132:135], v3, s[56:59], s85 offen offset:2304 nt
    s_cmp_lg_u32 s21, 0
    s_cbranch_scc1 L_pi16
    ds_read_b32 v13, v37 offset:4
    s_waitcnt lgkmcnt(0)
    v_readfirstlane_b32 s21, v13
    s_nop 3
    s_cmp_lg_u32 s21, 0
    s_cbranch_scc1 L_pi16
    s_waitcnt vmcnt(4)
L_pi16:
    s_mov_b32 s90, 0
    buffer_load_dwordx4 v[136:139], v39, s[36:39], s90 offen
    s_mov_b32 s90, 896
    buffer_load_dwordx4 v[140:143], v39, s[36:39], s90 offen
    s_mov_b32 s90, 1792
    buffer_load_dwordx4 v[144:147], v39, s[36:39], s90 offen
    s_mov_b32 s90, 2688
    buffer_load_dwordx4 v[148:151], v39, s[36:39], s90 offen
    s_cmp_lg_u32 s21, 0
    s_cbranch_scc1 L_pi20
    ds_read_b32 v13, v37 offset:4
    s_waitcnt lgkmcnt(0)
    v_readfirstlane_b32 s21, v13
    s_nop 3
    s_cmp_lg_u32 s21, 0
    s_cbranch_scc1 L_pi20
    s_waitcnt vmcnt(4)
L_pi20:
    s_mov_b32 s90, 3584
    buffer_load_dwordx4 v[152:155], v39, s[36:39], s90 offen
    s_mov_b32 s90, 4480
    buffer_load_dwordx4 v[156:159], v39, s[36:39], s90 offen
    s_mov_b32 s90, 5376
    buffer_load_dwordx4 v[160:163], v39, s[36:39], s90 offen
    s_mov_b32 s90, 6272
    buffer_load_dwordx4 v[164:167], v39, s[36:39], s90 offen
    s_cmp_lg_u32 s21, 0
    s_cbranch_scc1 L_pi24
    ds_read_b32 v13, v37 offset:4
    s_waitcnt lgkmcnt(0)
    v_readfirstlane_b32 s21, v13
    s_nop 3
    s_cmp_lg_u32 s21, 0
    s_cbranch_scc1 L_pi24
    s_waitcnt vmcnt(4)
L_pi24:
    s_mov_b32 s90, 7168
    buffer_load_dwordx4 v[168:171], v39, s[36:39], s90 offen
    s_mov_b32 s90, 8064
    buffer_load_dwordx4 v[172:175], v39, s[36:39], s90 offen
    s_mov_b32 s90, 8960
    buffer_load_dwordx4 v[176:179], v39, s[36:39], s90 offen
    s_mov_b32 s90, 9856
    buffer_load_dwordx4 v[180:183], v39, s[36:39], s90 offen
    s_cmp_lg_u32 s21, 0
    s_cbranch_scc1 L_pi28
    ds_read_b32 v13, v37 offset:4
    s_waitcnt lgkmcnt(0)
    v_readfirstlane_b32 s21, v13
    s_nop 3
    s_cmp_lg_u32 s21, 0
    s_cbranch_scc1 L_pi28
    s_waitcnt vmcnt(4)
L_pi28:
    s_mov_b32 s90, 10752
    buffer_load_dwordx4 v[184:187], v39, s[36:39], s90 offen
    s_mov_b32 s90, 11648
    buffer_load_dwordx4 v[188:191], v39, s[36:39], s90 offen
    s_mov_b32 s90, 12544
    buffer_load_dwordx4 v[192:195], v39, s[36:39], s90 offen
    s_mov_b32 s90, 13440
    buffer_load_dwordx4 v[196:199], v39, s[36:39], s90 offen
    s_mov_b32 s88, 2097152
L_wflag:
    s_cmp_lg_u32 s21, 0
    s_cbranch_scc1 L_go
    ds_read_b32 v13, v37 offset:4
    s_waitcnt lgkmcnt(0)
    v_readfirstlane_b32 s21, v13
    s_nop 3
    s_cmp_lg_u32 s21, 0
    s_cbranch_scc1 L_go
    s_sub_u32 s88, s88, 1
    s_cbranch_scc0 L_wflag
L_go:
    v_lshrrev_b32 v12, 3, v11
    v_lshlrev_b32 v12, 9, v12
    v_lshl_add_u32 v12, v10, 6, v12
    v_and_b32 v13, 3, v1
    v_lshl_add_u32 v12, v13, 4, v12
    ds_read_b128 v[16:19], v12 offset:4096
    ds_read_b128 v[20:23], v12 offset:4352
L_bench:
    v_mov_b32 v8, 0xff800000
    v_mov_b32 v9, 0
    v_mov_b32 v24, 0
    v_mov_b32 v25, 0
    v_mov_b32 v26, 0
    v_mov_b32 v27, 0
    v_mov_b32 v28, 0
    v_mov_b32 v29, 0
    v_mov_b32 v30, 0
    v_mov_b32 v31, 0
    s_waitcnt lgkmcnt(0)
    s_waitcnt vmcnt(30)
    s_lshl_b32 s84, s99, 13
    s_add_u32 s85, s84, 4096
    s_cmp_ge_u32 s99, 512
    s_cbranch_scc1 L_ntk0
    s_mov_b64 exec, 1
    ds_add_rtn_u32 v36, v37, v38
    s_mov_b64 exec, -1
L_ntk0:
    v_mfma_f32_16x16x32_bf16 v[40:43], v[72:75], v[16:19], 0
    v_mfma_f32_16x16x32_bf16 v[40:43], v[76:79], v[20:23], v[40:43]
    buffer_load_dwordx4 v[72:75], v2, s[52:55], s84 offen offset:0 nt
    buffer_load_dwordx4 v[76:79], v2, s[52:55], s84 offen offset:256 nt
    s_waitcnt vmcnt(30)
    v_mfma_f32_16x16x32_bf16 v[44:47], v[80:83], v[16:19], 0
    v_mfma_f32_16x16x32_bf16 v[44:47], v[84:87], v[20:23], v[44:47]
    buffer_load_dwordx4 v[80:83], v2, s[52:55], s84 offen offset:2048 nt
    buffer_load_dwordx4 v[84:87], v2, s[52:55], s84 offen offset:2304 nt
    s_waitcnt vmcnt(30)
    v_mfma_f32_16x16x32_bf16 v[48:51], v[88:91], v[16:19], 0
    v_mfma_f32_16x16x32_bf16 v[48:51], v[92:95], v[20:23], v[48:51]
    buffer_load_dwordx4 v[88:91], v2, s[52:55], s85 offen offset:0 nt
    buffer_load_dwordx4 v[92:95], v2, s[52:55], s85 offen offset:256 nt
    s_waitcnt vmcnt(30)
    v_mfma_f32_16x16x32_bf16 v[52:55], v[96:99], v[16:19], 0
    v_mfma_f32_16x16x32_bf16 v[52:55], v[100:103], v[20:23], v[52:55]
    buffer_load_dwordx4 v[96:99], v2, s[52:55], s85 offen offset:2048 nt
    buffer_load_dwordx4 v[100:103], v2, s[52:55], s85 offen offset:2304 nt
    s_waitcnt lgkmcnt(0)
    v_readfirstlane_b32 s51, v36
    s_nop 3
    s_cmp_ge_u32 s99, 512
    s_cbranch_scc1 L_inv0
    s_cmp_ge_u32 s51, 112
    s_cbranch_scc1 L_pool0
    s_add_u32 s51, s51, s43
    s_branch L_tkd0
L_pool0:
    s_mov_b32 s100, 1
    s_atomic_add s100, s[66:67], 0 glc
    s_mov_b32 s101, 1
    s_branch L_tkd0
L_inv0:
    s_mov_b32 s51, 512
L_tkd0:
    v_mov_b32_dpp v32, v40 quad_perm:[0,0,0,0] row_mask:0xf bank_mask:0xf
    v_add_f32_dpp v32, v41, v32 quad_perm:[1,1,1,1] row_mask:0xf bank_mask:0xf
    v_add_f32_dpp v32, v42, v32 quad_perm:[2,2,2,2] row_mask:0xf bank_mask:0xf
    v_add_f32_dpp v32, v43, v32 quad_perm:[3,3,3,3] row_mask:0xf bank_mask:0xf
    v_mov_b32_dpp v33, v44 quad_perm:[0,0,0,0] row_mask:0xf bank_mask:0xf
    v_add_f32_dpp v33, v45, v33 quad_perm:[1,1,1,1] row_mask:0xf bank_mask:0xf
    v_add_f32_dpp v33, v46, v33 quad_perm:[2,2,2,2] row_mask:0xf bank_mask:0xf
    v_add_f32_dpp v33, v47, v33 quad_perm:[3,3,3,3] row_mask:0xf bank_mask:0xf
    v_mov_b32_dpp v34, v48 quad_perm:[0,0,0,0] row_mask:0xf bank_mask:0xf
    v_add_f32_dpp v34, v49, v34 quad_perm:[1,1,1,1] row_mask:0xf bank_mask:0xf
    v_add_f32_dpp v34, v50, v34 quad_perm:[2,2,2,2] row_mask:0xf bank_mask:0xf
    v_add_f32_dpp v34, v51, v34 quad_perm:[3,3,3,3] row_mask:0xf bank_mask:0xf
    v_mov_b32_dpp v35, v52 quad_perm:[0,0,0,0] row_mask:0xf bank_mask:0xf
    v_add_f32_dpp v35, v53, v35 quad_perm:[1,1,1,1] row_mask:0xf bank_mask:0xf
    v_add_f32_dpp v35, v54, v35 quad_perm:[2,2,2,2] row_mask:0xf bank_mask:0xf
    v_add_f32_dpp v35, v55, v35 quad_perm:[3,3,3,3] row_mask:0xf bank_mask:0xf
    v_max3_f32 v10, v32, v33, v34
    v_max_f32 v10, v10, v35
    v_mov_b32 v11, v10
    s_nop 1
    v_permlane32_swap_b32 v10, v11
    s_nop 0
    v_max_f32 v10, v10, v11
    v_mov_b32 v11, v10
    s_nop 1
    v_permlane16_swap_b32 v10, v11
    s_nop 0
    v_max_f32 v10, v10, v11
    v_mul_f32 v10, s92, v10
    v_max_f32 v10, v10, v8
    v_sub_f32 v11, v8, v10
    v_exp_f32 v11, v11
    v_mov_b32 v8, v10
    v_fma_f32 v32, v32, s92, -v10
    v_fma_f32 v33, v33, s92, -v10
    v_fma_f32 v34, v34, s92, -v10
    v_fma_f32 v35, v35, s92, -v10
    v_exp_f32 v32, v32
    v_exp_f32 v33, v33
    v_exp_f32 v34, v34
    v_exp_f32 v35, v35
    v_mul_f32 v24, v24, v11
    v_mul_f32 v25, v25, v11
    v_mul_f32 v26, v26, v11
    v_mul_f32 v27, v27, v11
    v_mul_f32 v28, v28, v11
    v_mul_f32 v29, v29, v11
    v_mul_f32 v30, v30, v11
    v_mul_f32 v31, v31, v11
    v_mul_f32 v9, v9, v11
    v_cvt_pk_bf16_f32 v12, v32, v32
    v_add_f32 v9, v9, v32
    v_and_b32 v40, v12, v4
    v_and_b32 v41, v12, v5
    v_and_b32 v42, v12, v6
    v_and_b32 v43, v12, v7
    v_cvt_pk_bf16_f32 v12, v33, v33
    v_add_f32 v9, v9, v33
    v_and_b32 v44, v12, v4
    v_and_b32 v45, v12, v5
    v_and_b32 v46, v12, v6
    v_and_b32 v47, v12, v7
    v_cvt_pk_bf16_f32 v12, v34, v34
    v_add_f32 v9, v9, v34
    v_and_b32 v48, v12, v4
    v_and_b32 v49, v12, v5
    v_and_b32 v50, v12, v6
    v_and_b32 v51, v12, v7
    v_cvt_pk_bf16_f32 v12, v35, v35
    v_add_f32 v9, v9, v35
    v_and_b32 v52, v12, v4
    v_and_b32 v53, v12, v5
    v_and_b32 v54, v12, v6
    v_and_b32 v55, v12, v7
    s_nop 1
    s_waitcnt vmcnt(30)
    v_mfma_f32_16x16x32_bf16 v[24:27], v[104:107], v[40:43], v[24:27]
    v_mfma_f32_16x16x32_bf16 v[28:31], v[108:111], v[40:43], v[28:31]
    buffer_load_dwordx4 v[104:107], v3, s[56:59], s84 offen offset:0 nt
    buffer_load_dwordx4 v[108:111], v3, s[56:59], s84 offen offset:256 nt
    s_waitcnt vmcnt(30)
    v_mfma_f32_16x16x32_bf16 v[24:27], v[112:115], v[44:47], v[24:27]
    v_mfma_f32_16x16x32_bf16 v[28:31], v[116:119], v[44:47], v[28:31]
    buffer_load_dwordx4 v[112:115], v3, s[56:59], s84 offen offset:2048 nt
    buffer_load_dwordx4 v[116:119], v3, s[56:59], s84 offen offset:2304 nt
    s_waitcnt vmcnt(30)
    v_mfma_f32_16x16x32_bf16 v[24:27], v[120:123], v[48:51], v[24:27]
    v_mfma_f32_16x16x32_bf16 v[28:31], v[124:127], v[48:51], v[28:31]
    buffer_load_dwordx4 v[120:123], v3, s[56:59], s85 offen offset:0 nt
    buffer_load_dwordx4 v[124:127], v3, s[56:59], s85 offen offset:256 nt
    s_waitcnt vmcnt(30)
    v_mfma_f32_16x16x32_bf16 v[24:27], v[128:131], v[52:55], v[24:27]
    v_mfma_f32_16x16x32_bf16 v[28:31], v[132:135], v[52:55], v[28:31]
    buffer_load_dwordx4 v[128:131], v3, s[56:59], s85 offen offset:2048 nt
    buffer_load_dwordx4 v[132:135], v3, s[56:59], s85 offen offset:2304 nt
    s_mov_b32 s98, s99
    s_mov_b32 s99, s51
    s_cmp_ge_u32 s98, 512
    s_cbranch_scc1 L_loopdone
.p2align 6
L_loop:
    s_waitcnt vmcnt(14)
    s_cmp_eq_u32 s101, 0
    s_cbranch_scc1 L_np1
    s_waitcnt lgkmcnt(0)
    s_mov_b32 s99, s100
    s_mov_b32 s101, 0
L_np1:
    s_lshl_b32 s84, s99, 13
    s_add_u32 s85, s84, 4096
    s_cmp_ge_u32 s99, 512
    s_cbranch_scc1 L_ntk1
    s_mov_b64 exec, 1
    ds_add_rtn_u32 v36, v37, v38
    s_mov_b64 exec, -1
L_ntk1:
    v_mfma_f32_16x16x32_bf16 v[40:43], v[72:75], v[16:19], 0
    v_mfma_f32_16x16x32_bf16 v[40:43], v[76:79], v[20:23], v[40:43]
    buffer_load_dwordx4 v[72:75], v2, s[52:55], s84 offen offset:0 nt
    buffer_load_dwordx4 v[76:79], v2, s[52:55], s84 offen offset:256 nt
    s_waitcnt vmcnt(14)
    v_mfma_f32_16x16x32_bf16 v[44:47], v[80:83], v[16:19], 0
    v_mfma_f32_16x16x32_bf16 v[44:47], v[84:87], v[20:23], v[44:47]
    buffer_load_dwordx4 v[80:83], v2, s[52:55], s84 offen offset:2048 nt
    buffer_load_dwordx4 v[84:87], v2, s[52:55], s84 offen offset:2304 nt
    s_waitcnt vmcnt(14)
    v_mfma_f32_16x16x32_bf16 v[48:51], v[88:91], v[16:19], 0
    v_mfma_f32_16x16x32_bf16 v[48:51], v[92:95], v[20:23], v[48:51]
    buffer_load_dwordx4 v[88:91], v2, s[52:55], s85 offen offset:0 nt
    buffer_load_dwordx4 v[92:95], v2, s[52:55], s85 offen offset:256 nt
    s_waitcnt vmcnt(14)
    v_mfma_f32_16x16x32_bf16 v[52:55], v[96:99], v[16:19], 0
    v_mfma_f32_16x16x32_bf16 v[52:55], v[100:103], v[20:23], v[52:55]
    buffer_load_dwordx4 v[96:99], v2, s[52:55], s85 offen offset:2048 nt
    buffer_load_dwordx4 v[100:103], v2, s[52:55], s85 offen offset:2304 nt
    s_waitcnt lgkmcnt(0)
    v_readfirstlane_b32 s51, v36
    s_nop 3
    s_cmp_ge_u32 s99, 512
    s_cbranch_scc1 L_inv1
    s_cmp_ge_u32 s51, 112
    s_cbranch_scc1 L_pool1
    s_add_u32 s51, s51, s43
    s_branch L_tkd1
L_pool1:
    s_mov_b32 s100, 1
    s_atomic_add s100, s[66:67], 0 glc
    s_mov_b32 s101, 1
    s_branch L_tkd1
L_inv1:
    s_mov_b32 s51, 512
L_tkd1:
    v_mov_b32_dpp v32, v40 quad_perm:[0,0,0,0] row_mask:0xf bank_mask:0xf
    v_add_f32_dpp v32, v41, v32 quad_perm:[1,1,1,1] row_mask:0xf bank_mask:0xf
    v_add_f32_dpp v32, v42, v32 quad_perm:[2,2,2,2] row_mask:0xf bank_mask:0xf
    v_add_f32_dpp v32, v43, v32 quad_perm:[3,3,3,3] row_mask:0xf bank_mask:0xf
    v_mov_b32_dpp v33, v44 quad_perm:[0,0,0,0] row_mask:0xf bank_mask:0xf
    v_add_f32_dpp v33, v45, v33 quad_perm:[1,1,1,1] row_mask:0xf bank_mask:0xf
    v_add_f32_dpp v33, v46, v33 quad_perm:[2,2,2,2] row_mask:0xf bank_mask:0xf
    v_add_f32_dpp v33, v47, v33 quad_perm:[3,3,3,3] row_mask:0xf bank_mask:0xf
    v_mov_b32_dpp v34, v48 quad_perm:[0,0,0,0] row_mask:0xf bank_mask:0xf
    v_add_f32_dpp v34, v49, v34 quad_perm:[1,1,1,1] row_mask:0xf bank_mask:0xf
    v_add_f32_dpp v34, v50, v34 quad_perm:[2,2,2,2] row_mask:0xf bank_mask:0xf
    v_add_f32_dpp v34, v51, v34 quad_perm:[3,3,3,3] row_mask:0xf bank_mask:0xf
    v_mov_b32_dpp v35, v52 quad_perm:[0,0,0,0] row_mask:0xf bank_mask:0xf
    v_add_f32_dpp v35, v53, v35 quad_perm:[1,1,1,1] row_mask:0xf bank_mask:0xf
    v_add_f32_dpp v35, v54, v35 quad_perm:[2,2,2,2] row_mask:0xf bank_mask:0xf
    v_add_f32_dpp v35, v55, v35 quad_perm:[3,3,3,3] row_mask:0xf bank_mask:0xf
    v_max3_f32 v10, v32, v33, v34
    v_max_f32 v10, v10, v35
    v_mov_b32 v11, v10
    s_nop 1
    v_permlane32_swap_b32 v10, v11
    s_nop 0
    v_max_f32 v10, v10, v11
    v_mov_b32 v11, v10
    s_nop 1
    v_permlane16_swap_b32 v10, v11
    s_nop 0
    v_max_f32 v10, v10, v11
    v_mul_f32 v10, s92, v10
    v_max_f32 v10, v10, v8
    v_sub_f32 v11, v8, v10
    v_exp_f32 v11, v11
    v_mov_b32 v8, v10
    v_fma_f32 v32, v32, s92, -v10
    v_fma_f32 v33, v33, s92, -v10
    v_fma_f32 v34, v34, s92, -v10
    v_fma_f32 v35, v35, s92, -v10
    v_exp_f32 v32, v32
    v_exp_f32 v33, v33
    v_exp_f32 v34, v34
    v_exp_f32 v35, v35
    v_mul_f32 v24, v24, v11
    v_mul_f32 v25, v25, v11
    v_mul_f32 v26, v26, v11
    v_mul_f32 v27, v27, v11
    v_mul_f32 v28, v28, v11
    v_mul_f32 v29, v29, v11
    v_mul_f32 v30, v30, v11
    v_mul_f32 v31, v31, v11
    v_mul_f32 v9, v9, v11
    v_cvt_pk_bf16_f32 v12, v32, v32
    v_add_f32 v9, v9, v32
    v_and_b32 v40, v12, v4
    v_and_b32 v41, v12, v5
    v_and_b32 v42, v12, v6
    v_and_b32 v43, v12, v7
    v_cvt_pk_bf16_f32 v12, v33, v33
    v_add_f32 v9, v9, v33
    v_and_b32 v44, v12, v4
    v_and_b32 v45, v12, v5
    v_and_b32 v46, v12, v6
    v_and_b32 v47, v12, v7
    v_cvt_pk_bf16_f32 v12, v34, v34
    v_add_f32 v9, v9, v34
    v_and_b32 v48, v12, v4
    v_and_b32 v49, v12, v5
    v_and_b32 v50, v12, v6
    v_and_b32 v51, v12, v7
    v_cvt_pk_bf16_f32 v12, v35, v35
    v_add_f32 v9, v9, v35
    v_and_b32 v52, v12, v4
    v_and_b32 v53, v12, v5
    v_and_b32 v54, v12, v6
    v_and_b32 v55, v12, v7
    s_nop 1
    s_waitcnt vmcnt(14)
    v_mfma_f32_16x16x32_bf16 v[24:27], v[104:107], v[40:43], v[24:27]
    v_mfma_f32_16x16x32_bf16 v[28:31], v[108:111], v[40:43], v[28:31]
    buffer_load_dwordx4 v[104:107], v3, s[56:59], s84 offen offset:0 nt
    buffer_load_dwordx4 v[108:111], v3, s[56:59], s84 offen offset:256 nt
    s_waitcnt vmcnt(14)
    v_mfma_f32_16x16x32_bf16 v[24:27], v[112:115], v[44:47], v[24:27]
    v_mfma_f32_16x16x32_bf16 v[28:31], v[116:119], v[44:47], v[28:31]
    buffer_load_dwordx4 v[112:115], v3, s[56:59], s84 offen offset:2048 nt
    buffer_load_dwordx4 v[116:119], v3, s[56:59], s84 offen offset:2304 nt
    s_waitcnt vmcnt(14)
    v_mfma_f32_16x16x32_bf16 v[24:27], v[120:123], v[48:51], v[24:27]
    v_mfma_f32_16x16x32_bf16 v[28:31], v[124:127], v[48:51], v[28:31]
    buffer_load_dwordx4 v[120:123], v3, s[56:59], s85 offen offset:0 nt
    buffer_load_dwordx4 v[124:127], v3, s[56:59], s85 offen offset:256 nt
    s_waitcnt vmcnt(14)
    v_mfma_f32_16x16x32_bf16 v[24:27], v[128:131], v[52:55], v[24:27]
    v_mfma_f32_16x16x32_bf16 v[28:31], v[132:135], v[52:55], v[28:31]
    buffer_load_dwordx4 v[128:131], v3, s[56:59], s85 offen offset:2048 nt
    buffer_load_dwordx4 v[132:135], v3, s[56:59], s85 offen offset:2304 nt
    s_mov_b32 s98, s99
    s_mov_b32 s99, s51
    s_cmp_lt_u32 s98, 512
    s_cbranch_scc1 L_loop
L_loopdone:
    s_waitcnt vmcnt(0) lgkmcnt(0)
    v_and_b32 v61, 255, v0
    s_cmp_ge_u32 s18, 4
    s_cselect_b32 s23, 1, 0
    v_lshrrev_b32 v10, 4, v1
    v_and_b32 v11, 15, v1
    v_mov_b32 v12, v9
    s_nop 1
    v_permlane32_swap_b32 v9, v12
    s_nop 0
    v_add_f32 v9, v9, v12
    v_mov_b32 v12, v9
    s_nop 1
    v_permlane16_swap_b32 v9, v12
    s_nop 0
    v_add_f32 v9, v9, v12
    v_lshrrev_b32 v12, 3, v11
    s_lshl_b32 s89, s18, 4
    v_lshlrev_b32 v13, 3, v12
    v_add_u32 v13, s89, v13
    ds_write_b64 v13, v[8:9] offset:5120
    v_lshlrev_b32 v13, 10, v12
    v_lshl_add_u32 v13, v10, 7, v13
    v_and_b32 v14, 7, v1
    v_lshl_add_u32 v13, v14, 2, v13
    s_lshl_b32 s89, s18, 11
    v_add_u32 v13, s89, v13
    s_nop 7
    ds_write_b32 v13, v24 offset:8192
    ds_write_b32 v13, v25 offset:8224
    ds_write_b32 v13, v26 offset:8256
    ds_write_b32 v13, v27 offset:8288
    ds_write_b32 v13, v28 offset:8704
    ds_write_b32 v13, v29 offset:8736
    ds_write_b32 v13, v30 offset:8768
    ds_write_b32 v13, v31 offset:8800
    s_waitcnt lgkmcnt(0)
    s_barrier
    s_cmp_eq_u32 s23, 1
    s_cbranch_scc1 L_comb_done
L_partB:
    v_lshlrev_b32 v12, 4, v61
    v_lshrrev_b32 v10, 7, v61
    v_lshlrev_b32 v11, 4, v10
    s_lshl_b32 s89, s19, 15
    s_add_u32 s89, s89, 1048576
    s_add_u32 s90, s15, 1
    s_and_b32 s90, s90, 3
    s_lshl_b32 s90, s90, 13
    s_add_u32 s90, s90, s89
    buffer_load_dwordx4 v[80:83], v12, s[72:75], s90 offen offset:64 sc1
    buffer_load_dwordx4 v[84:87], v11, s[72:75], s90 offen sc1
    s_add_u32 s90, s15, 2
    s_and_b32 s90, s90, 3
    s_lshl_b32 s90, s90, 13
    s_add_u32 s90, s90, s89
    buffer_load_dwordx4 v[88:91], v12, s[72:75], s90 offen offset:64 sc1
    buffer_load_dwordx4 v[92:95], v11, s[72:75], s90 offen sc1
    s_add_u32 s90, s15, 3
    s_and_b32 s90, s90, 3
    s_lshl_b32 s90, s90, 13
    s_add_u32 s90, s90, s89
    buffer_load_dwordx4 v[96:99], v12, s[72:75], s90 offen offset:64 sc1
    buffer_load_dwordx4 v[100:103], v11, s[72:75], s90 offen sc1
L_d1:
    v_lshlrev_b32 v13, 3, v10
    v_lshlrev_b32 v14, 3, v61
    ds_read_b64 v[40:41], v13 offset:5120
    ds_read_b64 v[42:43], v13 offset:5136
    ds_read_b64 v[44:45], v13 offset:5152
    ds_read_b64 v[46:47], v13 offset:5168
    ds_read_b64 v[48:49], v13 offset:5184
    ds_read_b64 v[50:51], v13 offset:5200
    ds_read_b64 v[52:53], v13 offset:5216
    ds_read_b64 v[54:55], v13 offset:5232
    ds_read_b64 v[104:105], v14 offset:8192
    ds_read_b64 v[106:107], v14 offset:10240
    ds_read_b64 v[108:109], v14 offset:12288
    ds_read_b64 v[110:111], v14 offset:14336
    ds_read_b64 v[112:113], v14 offset:16384
    ds_read_b64 v[114:115], v14 offset:18432
    ds_read_b64 v[116:117], v14 offset:20480
    ds_read_b64 v[118:119], v14 offset:22528
    s_waitcnt lgkmcnt(0)
    v_max3_f32 v76, v40, v42, v44
    v_max3_f32 v76, v76, v46, v48
    v_max3_f32 v76, v76, v50, v52
    v_max_f32 v76, v76, v54
    v_sub_f32 v40, v40, v76
    v_sub_f32 v42, v42, v76
    v_sub_f32 v44, v44, v76
    v_sub_f32 v46, v46, v76
    v_sub_f32 v48, v48, v76
    v_sub_f32 v50, v50, v76
    v_sub_f32 v52, v52, v76
    v_sub_f32 v54, v54, v76
    v_exp_f32 v40, v40
    v_exp_f32 v42, v42
    v_exp_f32 v44, v44
    v_exp_f32 v46, v46
    v_exp_f32 v48, v48
    v_exp_f32 v50, v50
    v_exp_f32 v52, v52
    v_exp_f32 v54, v54
    s_nop 0
    v_mul_f32 v78, v40, v41
    v_mul_f32 v72, v40, v104
    v_mul_f32 v74, v40, v105
    v_fmac_f32 v78, v42, v43
    v_fmac_f32 v72, v42, v106
    v_fmac_f32 v74, v42, v107
    v_fmac_f32 v78, v44, v45
    v_fmac_f32 v72, v44, v108
    v_fmac_f32 v74, v44, v109
    v_fmac_f32 v78, v46, v47
    v_fmac_f32 v72, v46, v110
    v_fmac_f32 v74, v46, v111
    v_fmac_f32 v78, v48, v49
    v_fmac_f32 v72, v48, v112
    v_fmac_f32 v74, v48, v113
    v_fmac_f32 v78, v50, v51
    v_fmac_f32 v72, v50, v114
    v_fmac_f32 v74, v50, v115
    v_fmac_f32 v78, v52, v53
    v_fmac_f32 v72, v52, v116
    v_fmac_f32 v74, v52, v117
    v_fmac_f32 v78, v54, v55
    v_fmac_f32 v72, v54, v118
    v_fmac_f32 v74, v54, v119
    v_mov_b32 v73, s76
    v_mov_b32 v75, s77
    v_mov_b32 v77, s76
    v_mov_b32 v79, s77
    s_add_u32 s90, s15, 0
    s_and_b32 s90, s90, 3
    s_lshl_b32 s90, s90, 13
    s_add_u32 s90, s90, s89
    buffer_store_dwordx4 v[72:75], v12, s[72:75], s90 offen offset:64 sc1
    v_and_b32 v13, 127, v61
    v_cmp_eq_u32 vcc, 0, v13
    s_and_saveexec_b64 s[96:97], vcc
    s_cbranch_execz L_noml
    buffer_store_dwordx4 v[76:79], v11, s[72:75], s90 offen sc1
L_noml:
    s_mov_b64 exec, -1
L_d2:
    s_mov_b32 s88, 131072
    s_cmp_eq_u32 s23, 2
    s_cselect_b32 s22, 15, 1
    s_branch L_p2chk
L_poll2:
    s_bitcmp1_b32 s22, 1
    s_cbranch_scc1 L_p2s1
    s_add_u32 s90, s15, 1
    s_and_b32 s90, s90, 3
    s_lshl_b32 s90, s90, 13
    s_add_u32 s90, s90, s89
    buffer_load_dwordx4 v[80:83], v12, s[72:75], s90 offen offset:64 sc1
    buffer_load_dwordx4 v[84:87], v11, s[72:75], s90 offen sc1
L_p2s1:
    s_bitcmp1_b32 s22, 2
    s_cbranch_scc1 L_p2s2
    s_add_u32 s90, s15, 2
    s_and_b32 s90, s90, 3
    s_lshl_b32 s90, s90, 13
    s_add_u32 s90, s90, s89
    buffer_load_dwordx4 v[88:91], v12, s[72:75], s90 offen offset:64 sc1
    buffer_load_dwordx4 v[92:95], v11, s[72:75], s90 offen sc1
L_p2s2:
    s_bitcmp1_b32 s22, 3
    s_cbranch_scc1 L_p2s3
    s_add_u32 s90, s15, 3
    s_and_b32 s90, s90, 3
    s_lshl_b32 s90, s90, 13
    s_add_u32 s90, s90, s89
    buffer_load_dwordx4 v[96:99], v12, s[72:75], s90 offen offset:64 sc1
    buffer_load_dwordx4 v[100:103], v11, s[72:75], s90 offen sc1
L_p2s3:
L_p2chk:
    s_waitcnt vmcnt(0)
L_p2chk2:
    v_cmp_ne_u32 vcc, s76, v81
    v_cmp_ne_u32 s[96:97], s77, v83
    s_or_b64 vcc, vcc, s[96:97]
    v_cmp_ne_u32 s[96:97], s76, v85
    s_or_b64 vcc, vcc, s[96:97]
    v_cmp_ne_u32 s[96:97], s77, v87
    s_or_b64 vcc, vcc, s[96:97]
    s_cmp_eq_u64 vcc, 0
    s_cselect_b32 s90, 2, 0
    s_or_b32 s22, s22, s90
    v_cmp_ne_u32 vcc, s76, v89
    v_cmp_ne_u32 s[96:97], s77, v91
    s_or_b64 vcc, vcc, s[96:97]
    v_cmp_ne_u32 s[96:97], s76, v93
    s_or_b64 vcc, vcc, s[96:97]
    v_cmp_ne_u32 s[96:97], s77, v95
    s_or_b64 vcc, vcc, s[96:97]
    s_cmp_eq_u64 vcc, 0
    s_cselect_b32 s90, 4, 0
    s_or_b32 s22, s22, s90
    v_cmp_ne_u32 vcc, s76, v97
    v_cmp_ne_u32 s[96:97], s77, v99
    s_or_b64 vcc, vcc, s[96:97]
    v_cmp_ne_u32 s[96:97], s76, v101
    s_or_b64 vcc, vcc, s[96:97]
    v_cmp_ne_u32 s[96:97], s77, v103
    s_or_b64 vcc, vcc, s[96:97]
    s_cmp_eq_u64 vcc, 0
    s_cselect_b32 s90, 8, 0
    s_or_b32 s22, s22, s90
    s_sub_u32 s88, s88, 1
    s_cbranch_scc1 L_poll2_done
    s_cmp_lg_u32 s22, 15
    s_cbranch_scc1 L_poll2
L_poll2_done:
    v_max3_f32 v13, v76, v84, v92
    v_max_f32 v13, v13, v100
    v_sub_f32 v76, v76, v13
    v_sub_f32 v84, v84, v13
    v_sub_f32 v92, v92, v13
    v_sub_f32 v100, v100, v13
    v_exp_f32 v76, v76
    v_exp_f32 v84, v84
    v_exp_f32 v92, v92
    v_exp_f32 v100, v100
    s_nop 0
    v_mul_f32 v14, v76, v78
    v_mul_f32 v15, v76, v72
    v_mul_f32 v13, v76, v74
    v_fmac_f32 v14, v84, v86
    v_fmac_f32 v15, v84, v80
    v_fmac_f32 v13, v84, v82
    v_fmac_f32 v14, v92, v94
    v_fmac_f32 v15, v92, v88
    v_fmac_f32 v13, v92, v90
    v_fmac_f32 v14, v100, v102
    v_fmac_f32 v15, v100, v96
    v_fmac_f32 v13, v100, v98
    v_rcp_f32 v14, v14
    s_nop 0
    v_mul_f32 v15, v15, v14
    v_mul_f32 v13, v13, v14
    v_cvt_pk_bf16_f32 v15, v15, v13
    v_lshlrev_b32 v13, 2, v61
    ds_write_b32 v13, v15 offset:5376
    s_waitcnt lgkmcnt(0)
L_comb_done:
    s_barrier
L_d3:
    v_lshrrev_b32 v10, 4, v1
    s_lshl_b32 s89, s18, 7
    v_lshlrev_b32 v12, 5, v10
    v_add_u32 v12, s89, v12
    ds_read_b128 v[40:43], v12 offset:5376
    ds_read_b128 v[44:47], v12 offset:5392
    s_waitcnt vmcnt(0) lgkmcnt(0)
    v_perm_b32 v60, v40, v40, s93
    v_and_b32 v48, v60, v4
    v_and_b32 v49, v60, v5
    v_and_b32 v50, v60, v6
    v_and_b32 v51, v60, v7
    s_nop 1
    v_mfma_f32_16x16x32_bf16 v[56:59], v[136:139], v[48:51], 0
    v_perm_b32 v60, v40, v40, s94
    v_and_b32 v52, v60, v4
    v_and_b32 v53, v60, v5
    v_and_b32 v54, v60, v6
    v_and_b32 v55, v60, v7
    s_nop 1
    v_mfma_f32_16x16x32_bf16 v[56:59], v[140:143], v[52:55], v[56:59]
    v_perm_b32 v60, v41, v41, s93
    v_and_b32 v48, v60, v4
    v_and_b32 v49, v60, v5
    v_and_b32 v50, v60, v6
    v_and_b32 v51, v60, v7
    s_nop 1
    v_mfma_f32_16x16x32_bf16 v[56:59], v[144:147], v[48:51], v[56:59]
    v_perm_b32 v60, v41, v41, s94
    v_and_b32 v52, v60, v4
    v_and_b32 v53, v60, v5
    v_and_b32 v54, v60, v6
    v_and_b32 v55, v60, v7
    s_nop 1
    v_mfma_f32_16x16x32_bf16 v[56:59], v[148:151], v[52:55], v[56:59]
    v_perm_b32 v60, v42, v42, s93
    v_and_b32 v48, v60, v4
    v_and_b32 v49, v60, v5
    v_and_b32 v50, v60, v6
    v_and_b32 v51, v60, v7
    s_nop 1
    v_mfma_f32_16x16x32_bf16 v[56:59], v[152:155], v[48:51], v[56:59]
    v_perm_b32 v60, v42, v42, s94
    v_and_b32 v52, v60, v4
    v_and_b32 v53, v60, v5
    v_and_b32 v54, v60, v6
    v_and_b32 v55, v60, v7
    s_nop 1
    v_mfma_f32_16x16x32_bf16 v[56:59], v[156:159], v[52:55], v[56:59]
    v_perm_b32 v60, v43, v43, s93
    v_and_b32 v48, v60, v4
    v_and_b32 v49, v60, v5
    v_and_b32 v50, v60, v6
    v_and_b32 v51, v60, v7
    s_nop 1
    v_mfma_f32_16x16x32_bf16 v[56:59], v[160:163], v[48:51], v[56:59]
    v_perm_b32 v60, v43, v43, s94
    v_and_b32 v52, v60, v4
    v_and_b32 v53, v60, v5
    v_and_b32 v54, v60, v6
    v_and_b32 v55, v60, v7
    s_nop 1
    v_mfma_f32_16x16x32_bf16 v[56:59], v[164:167], v[52:55], v[56:59]
    v_perm_b32 v60, v44, v44, s93
    v_and_b32 v48, v60, v4
    v_and_b32 v49, v60, v5
    v_and_b32 v50, v60, v6
    v_and_b32 v51, v60, v7
    s_nop 1
    v_mfma_f32_16x16x32_bf16 v[56:59], v[168:171], v[48:51], v[56:59]
    v_perm_b32 v60, v44, v44, s94
    v_and_b32 v52, v60, v4
    v_and_b32 v53, v60, v5
    v_and_b32 v54, v60, v6
    v_and_b32 v55, v60, v7
    s_nop 1
    v_mfma_f32_16x16x32_bf16 v[56:59], v[172:175], v[52:55], v[56:59]
    v_perm_b32 v60, v45, v45, s93
    v_and_b32 v48, v60, v4
    v_and_b32 v49, v60, v5
    v_and_b32 v50, v60, v6
    v_and_b32 v51, v60, v7
    s_nop 1
    v_mfma_f32_16x16x32_bf16 v[56:59], v[176:179], v[48:51], v[56:59]
    v_perm_b32 v60, v45, v45, s94
    v_and_b32 v52, v60, v4
    v_and_b32 v53, v60, v5
    v_and_b32 v54, v60, v6
    v_and_b32 v55, v60, v7
    s_nop 1
    v_mfma_f32_16x16x32_bf16 v[56:59], v[180:183], v[52:55], v[56:59]
    v_perm_b32 v60, v46, v46, s93
    v_and_b32 v48, v60, v4
    v_and_b32 v49, v60, v5
    v_and_b32 v50, v60, v6
    v_and_b32 v51, v60, v7
    s_nop 1
    v_mfma_f32_16x16x32_bf16 v[56:59], v[184:187], v[48:51], v[56:59]
    v_perm_b32 v60, v46, v46, s94
    v_and_b32 v52, v60, v4
    v_and_b32 v53, v60, v5
    v_and_b32 v54, v60, v6
    v_and_b32 v55, v60, v7
    s_nop 1
    v_mfma_f32_16x16x32_bf16 v[56:59], v[188:191], v[52:55], v[56:59]
    v_perm_b32 v60, v47, v47, s93
    v_and_b32 v48, v60, v4
    v_and_b32 v49, v60, v5
    v_and_b32 v50, v60, v6
    v_and_b32 v51, v60, v7
    s_nop 1
    v_mfma_f32_16x16x32_bf16 v[56:59], v[192:195], v[48:51], v[56:59]
    v_perm_b32 v60, v47, v47, s94
    v_and_b32 v52, v60, v4
    v_and_b32 v53, v60, v5
    v_and_b32 v54, v60, v6
    v_and_b32 v55, v60, v7
    s_nop 1
    v_mfma_f32_16x16x32_bf16 v[56:59], v[196:199], v[52:55], v[56:59]
    v_and_b32 v12, 7, v1
    v_lshlrev_b32 v12, 2, v12
    v_lshl_add_u32 v12, v10, 7, v12
    s_lshl_b32 s89, s18, 9
    v_add_u32 v12, s89, v12
    s_nop 7
    ds_write_b32 v12, v56 offset:0
    ds_write_b32 v12, v57 offset:32
    ds_write_b32 v12, v58 offset:64
    ds_write_b32 v12, v59 offset:96
    s_waitcnt lgkmcnt(0)
    s_barrier
    s_cmp_lg_u32 s18, 0
    s_cbranch_scc1 L_end
L_d4:
    v_lshlrev_b32 v13, 1, v1
    v_cmp_gt_u32 vcc, s20, v13
    s_and_b64 exec, exec, vcc
    v_lshlrev_b32 v14, 3, v1
    ds_read_b64 v[40:41], v14 offset:0
    ds_read_b64 v[42:43], v14 offset:512
    ds_read_b64 v[44:45], v14 offset:1024
    ds_read_b64 v[46:47], v14 offset:1536
    ds_read_b64 v[48:49], v14 offset:2048
    ds_read_b64 v[50:51], v14 offset:2560
    ds_read_b64 v[52:53], v14 offset:3072
    ds_read_b64 v[54:55], v14 offset:3584
    s_lshl_b32 s89, s50, 13
    s_add_u32 s89, s89, 262144
    s_lshl_b32 s90, s14, 10
    s_add_u32 s90, s90, s89
    v_lshlrev_b32 v12, 4, v1
    s_waitcnt lgkmcnt(0)
    v_mov_b32 v72, v40
    v_mov_b32 v74, v41
    v_add_f32 v72, v72, v42
    v_add_f32 v74, v74, v43
    v_add_f32 v72, v72, v44
    v_add_f32 v74, v74, v45
    v_add_f32 v72, v72, v46
    v_add_f32 v74, v74, v47
    v_add_f32 v72, v72, v48
    v_add_f32 v74, v74, v49
    v_add_f32 v72, v72, v50
    v_add_f32 v74, v74, v51
    v_add_f32 v72, v72, v52
    v_add_f32 v74, v74, v53
    v_add_f32 v72, v72, v54
    v_add_f32 v74, v74, v55
    v_mov_b32 v73, s76
    v_mov_b32 v75, s77
    s_cmp_eq_u32 s14, s3
    s_cbranch_scc1 L_red
    buffer_store_dwordx4 v[72:75], v12, s[72:75], s90 offen sc1
    s_endpgm
L_red:
    s_mov_b32 s88, 131072
    s_cmp_eq_u32 s23, 2
    s_cselect_b32 s22, 255, 1
L_poll3:
    s_bitcmp1_b32 s22, 1
    s_cbranch_scc1 L_p3s1
    s_add_u32 s90, s14, 1
    s_and_b32 s90, s90, 7
    s_lshl_b32 s90, s90, 10
    s_add_u32 s90, s90, s89
    buffer_load_dwordx4 v[76:79], v12, s[72:75], s90 offen sc1
L_p3s1:
    s_bitcmp1_b32 s22, 2
    s_cbranch_scc1 L_p3s2
    s_add_u32 s90, s14, 2
    s_and_b32 s90, s90, 7
    s_lshl_b32 s90, s90, 10
    s_add_u32 s90, s90, s89
    buffer_load_dwordx4 v[80:83], v12, s[72:75], s90 offen sc1
L_p3s2:
    s_bitcmp1_b32 s22, 3
    s_cbranch_scc1 L_p3s3
    s_add_u32 s90, s14, 3
    s_and_b32 s90, s90, 7
    s_lshl_b32 s90, s90, 10
    s_add_u32 s90, s90, s89
    buffer_load_dwordx4 v[84:87], v12, s[72:75], s90 offen sc1
L_p3s3:
    s_bitcmp1_b32 s22, 4
    s_cbranch_scc1 L_p3s4
    s_add_u32 s90, s14, 4
    s_and_b32 s90, s90, 7
    s_lshl_b32 s90, s90, 10
    s_add_u32 s90, s90, s89
    buffer_load_dwordx4 v[88:91], v12, s[72:75], s90 offen sc1
L_p3s4:
    s_bitcmp1_b32 s22, 5
    s_cbranch_scc1 L_p3s5
    s_add_u32 s90, s14, 5
    s_and_b32 s90, s90, 7
    s_lshl_b32 s90, s90, 10
    s_add_u32 s90, s90, s89
    buffer_load_dwordx4 v[92:95], v12, s[72:75], s90 offen sc1
L_p3s5:
    s_bitcmp1_b32 s22, 6
    s_cbranch_scc1 L_p3s6
    s_add_u32 s90, s14, 6
    s_and_b32 s90, s90, 7
    s_lshl_b32 s90, s90, 10
    s_add_u32 s90, s90, s89
    buffer_load_dwordx4 v[96:99], v12, s[72:75], s90 offen sc1
L_p3s6:
    s_bitcmp1_b32 s22, 7
    s_cbranch_scc1 L_p3s7
    s_add_u32 s90, s14, 7
    s_and_b32 s90, s90, 7
    s_lshl_b32 s90, s90, 10
    s_add_u32 s90, s90, s89
    buffer_load_dwordx4 v[100:103], v12, s[72:75], s90 offen sc1
L_p3s7:
    s_waitcnt vmcnt(0)
    v_cmp_ne_u32 vcc, s76, v77
    v_cmp_ne_u32 s[96:97], s77, v79
    s_or_b64 vcc, vcc, s[96:97]
    s_cmp_eq_u64 vcc, 0
    s_cselect_b32 s90, 2, 0
    s_or_b32 s22, s22, s90
    v_cmp_ne_u32 vcc, s76, v81
    v_cmp_ne_u32 s[96:97], s77, v83
    s_or_b64 vcc, vcc, s[96:97]
    s_cmp_eq_u64 vcc, 0
    s_cselect_b32 s90, 4, 0
    s_or_b32 s22, s22, s90
    v_cmp_ne_u32 vcc, s76, v85
    v_cmp_ne_u32 s[96:97], s77, v87
    s_or_b64 vcc, vcc, s[96:97]
    s_cmp_eq_u64 vcc, 0
    s_cselect_b32 s90, 8, 0
    s_or_b32 s22, s22, s90
    v_cmp_ne_u32 vcc, s76, v89
    v_cmp_ne_u32 s[96:97], s77, v91
    s_or_b64 vcc, vcc, s[96:97]
    s_cmp_eq_u64 vcc, 0
    s_cselect_b32 s90, 16, 0
    s_or_b32 s22, s22, s90
    v_cmp_ne_u32 vcc, s76, v93
    v_cmp_ne_u32 s[96:97], s77, v95
    s_or_b64 vcc, vcc, s[96:97]
    s_cmp_eq_u64 vcc, 0
    s_cselect_b32 s90, 32, 0
    s_or_b32 s22, s22, s90
    v_cmp_ne_u32 vcc, s76, v97
    v_cmp_ne_u32 s[96:97], s77, v99
    s_or_b64 vcc, vcc, s[96:97]
    s_cmp_eq_u64 vcc, 0
    s_cselect_b32 s90, 64, 0
    s_or_b32 s22, s22, s90
    v_cmp_ne_u32 vcc, s76, v101
    v_cmp_ne_u32 s[96:97], s77, v103
    s_or_b64 vcc, vcc, s[96:97]
    s_cmp_eq_u64 vcc, 0
    s_cselect_b32 s90, 128, 0
    s_or_b32 s22, s22, s90
    s_sub_u32 s88, s88, 1
    s_cbranch_scc1 L_poll3_done
    s_cmp_lg_u32 s22, 255
    s_cbranch_scc1 L_poll3
L_poll3_done:
    v_add_f32 v72, v72, v76
    v_add_f32 v74, v74, v78
    v_add_f32 v72, v72, v80
    v_add_f32 v74, v74, v82
    v_add_f32 v72, v72, v84
    v_add_f32 v74, v74, v86
    v_add_f32 v72, v72, v88
    v_add_f32 v74, v74, v90
    v_add_f32 v72, v72, v92
    v_add_f32 v74, v74, v94
    v_add_f32 v72, v72, v96
    v_add_f32 v74, v74, v98
    v_add_f32 v72, v72, v100
    v_add_f32 v74, v74, v102
    v_cvt_pk_bf16_f32 v40, v72, v74
    s_mul_i32 s89, s16, 1792
    s_mul_i32 s90, s17, 896
    s_add_u32 s89, s89, s90
    s_lshl_b32 s90, s15, 8
    s_add_u32 s89, s89, s90
    v_lshlrev_b32 v12, 2, v1
    buffer_store_dword v40, v12, s[80:83], s89 offen
    s_cmp_lg_u32 s15, 0
    s_cbranch_scc1 L_end
    s_lshr_b32 s89, s2, 5
    s_lshl_b32 s89, s89, 7
    v_mov_b32 v12, s89
    v_mov_b32 v40, s78
    v_mov_b32 v41, s79
    s_mov_b64 exec, 1
    buffer_store_dwordx2 v[40:41], v12, s[72:75], 0 offen offset:0 sc1
L_end:
    s_endpgm
.section .rodata,"a"
.p2align 6
.amdhsa_kernel concat_heads__gqa_block_cached__gqa_block_cached__decode_kernel
  .amdhsa_next_free_vgpr 256
  .amdhsa_next_free_sgpr 102
  .amdhsa_accum_offset 256
  .amdhsa_group_segment_fixed_size 0
  .amdhsa_kernarg_size 104
  .amdhsa_user_sgpr_count 2
  .amdhsa_user_sgpr_kernarg_segment_ptr 1
  .amdhsa_system_sgpr_workgroup_id_x 1
.end_amdhsa_kernel
```
